```python
import torch

def _softmax(x, axis=-1):
    return torch.softmax(x, dim=axis)

def _gelu(x):
    return torch.nn.functional.gelu(x, approximate='tanh')

def _silu(x):
    return torch.nn.functional.silu(x)

def _sigmoid(x):
    return torch.sigmoid(x)

def _layernorm(x, axis=-1, eps=1e-05):
    m = x.mean(dim=axis, keepdim=True)
    v = x.var(dim=axis, keepdim=True, unbiased=False)
    return (x - m) / torch.sqrt(v + eps)

def _scatter_add(tgt, idx, src, axis=0):
    return tgt.clone().index_add_(axis, idx, src)

def _segment_sum(src, seg, n):
    out = torch.zeros((n,) + src.shape[1:], dtype=src.dtype)
    return out.index_add_(0, seg, src)

def _pad(x, pw):
    flat = tuple((v for pair in reversed(pw) for v in pair))
    return torch.nn.functional.pad(x, flat)
kernel_name = 'standalone__tree_speculative_verify_tree_attention_over_candidate_token_tree__decode'

def setup_inputs():

    _w = lambda a: (lambda t: t.to(torch.bfloat16) if t.is_floating_point() else t)(torch.as_tensor(a))
    B, Hq, Hkv, T, C, D = (4, 32, 32, 1, 8192, 128)
    tree_mask = torch.zeros((B, T, T), dtype=float)
    for b in range(B):
        parent = torch.zeros(T, dtype=torch.int64)
        for i in range(1, T):
            parent[i] = int(torch.randint(0, i, (1,)).item())
        for i in range(T):
            j = i
            tree_mask[b, i, j] = 1.0
            while j > 0:
                j = parent[j]
                tree_mask[b, i, j] = 1.0
    return {'q': _w((lambda *s: torch.randn(*s, dtype=torch.bfloat16) * 0.8)(B, Hq, T, D)), 'k_cache': _w((lambda *s: torch.randn(*s, dtype=torch.bfloat16) * 0.8)(B, Hkv, C, D)), 'v_cache': _w((lambda *s: torch.randn(*s, dtype=torch.bfloat16) * 0.05)(B, Hkv, C, D)), 'k_tree': _w((lambda *s: torch.randn(*s, dtype=torch.bfloat16) * 0.8)(B, Hkv, T, D)), 'v_tree': _w((lambda *s: torch.randn(*s, dtype=torch.bfloat16) * 0.05)(B, Hkv, T, D)), 'tree_mask': _w(tree_mask)}

def reference(q, k_cache, v_cache, k_tree, v_tree, tree_mask):
    B, Hq, T, D = q.shape
    Hkv, C = (k_cache.shape[1], k_cache.shape[2])
    rep = Hq // Hkv
    kc = (lambda x, n, axis: torch.repeat_interleave(x, n, dim=axis))(k_cache, rep, axis=1)
    vc = (lambda x, n, axis: torch.repeat_interleave(x, n, dim=axis))(v_cache, rep, axis=1)
    kt = (lambda x, n, axis: torch.repeat_interleave(x, n, dim=axis))(k_tree, rep, axis=1)
    vt = (lambda x, n, axis: torch.repeat_interleave(x, n, dim=axis))(v_tree, rep, axis=1)
    k = torch.concatenate([kc, kt], axis=2)
    v = torch.concatenate([vc, vt], axis=2)
    scale = D ** (-0.5)
    scores = torch.einsum('bhqd,bhkd->bhqk', q, k) * scale
    ctx_mask = torch.ones((B, 1, T, C), dtype=scores.dtype)
    tm = tree_mask[:, None, :, :].clone()
    full_mask = torch.concatenate([ctx_mask, tm], axis=-1)
    scores = scores + (1.0 - full_mask) * -1000000000.0
    p = _softmax(scores, axis=-1)
    return torch.einsum('bhqk,bhkd->bhqd', p, v)
```

```asm
; @launch grid=(256,1,1) block=(256,1,1) lds=65536
.amdgcn_target "amdgcn-amd-amdhsa--gfx950"
.text
.globl standalone__tree_speculative_verify_tree_attention_over_candidate_token_tree__decode_kernel
.p2align 8
.type standalone__tree_speculative_verify_tree_attention_over_candidate_token_tree__decode_kernel,@function
standalone__tree_speculative_verify_tree_attention_over_candidate_token_tree__decode_kernel:
    s_cmp_ge_u32 s2, 256
    s_cbranch_scc1 L_end
    s_load_dwordx16 s[4:19], s[0:1], 0
    s_load_dwordx2 s[20:21], s[0:1], 64
    v_lshrrev_b32 v31, 6, v0
    v_and_b32 v0, 63, v0
    v_readfirstlane_b32 s3, v31
    v_lshlrev_b32 v1, 4, v0
    v_and_b32 v31, 0xf0, v1
    s_and_b32 s23, s2, 7
    s_lshr_b32 s34, s2, 3
    s_lshl_b32 s34, s34, 2
    s_add_u32 s22, s34, s3
    s_lshl_b32 s36, s22, 8
    v_add_u32 v31, s36, v31
    s_lshl_b32 s34, s22, 21
    s_and_b32 s35, s23, 1
    s_lshr_b32 s61, s23, 1
    s_mul_i32 s60, s23, 8192
    s_mov_b32 s32, s60
    s_mov_b32 s26, 2097152
    s_mov_b32 s27, 0x20000
    s_mov_b32 s30, 2097152
    s_mov_b32 s31, 0x20000
    s_mov_b32 s58, 2097152
    s_mov_b32 s59, 0x20000
    s_waitcnt lgkmcnt(0)
    global_load_dwordx4 v[4:7], v31, s[4:5]
    s_add_u32 s24, s6, s34
    s_addc_u32 s25, s7, 0
    s_and_b32 s25, s25, 0xffff
    v_add_u32 v43, 4096, v1
    buffer_load_dwordx4 v[44:47], v1, s[24:27], s60 offen nt
    buffer_load_dwordx4 v[48:51], v1, s[24:27], s60 offen offset:1024 nt
    buffer_load_dwordx4 v[52:55], v1, s[24:27], s60 offen offset:2048 nt
    buffer_load_dwordx4 v[56:59], v1, s[24:27], s60 offen offset:3072 nt
    buffer_load_dwordx4 v[60:63], v43, s[24:27], s60 offen nt
    buffer_load_dwordx4 v[64:67], v43, s[24:27], s60 offen offset:1024 nt
    s_add_u32 s28, s8, s34
    s_addc_u32 s29, s9, 0
    s_and_b32 s29, s29, 0xffff
    s_mov_b64 s[56:57], s[24:25]
    s_mov_b32 s63, s60
    s_add_u32 s64, s60, 65536
    s_mul_i32 s61, s61, 2
    s_add_u32 s61, s61, 464
    s_lshl_b32 s61, s61, 12
    s_cmp_eq_u32 s35, 0
    s_cselect_b32 s62, 1, 0
    s_add_u32 s36, s36, 0x100000
    v_mov_b32 v34, s36
    v_mov_b32 v33, 1
    s_and_b32 s38, s22, 31
    s_lshl_b32 s38, 1, s38
    s_lshr_b32 s36, s22, 5
    s_lshl_b32 s36, s36, 2
    v_mov_b32 v35, s36
    s_mov_b32 s39, 0
    s_mul_i32 s36, s3, 16384
    v_lshlrev_b32 v38, 2, v0
    v_add_u32 v38, s36, v38
    v_mov_b32 v2, 0xff61b1e6
    v_mov_b32 v3, 0
    v_mov_b32 v12, 0
    v_mov_b32 v13, 0
    v_mov_b32 v14, 0
    v_mov_b32 v15, 0
    v_mov_b32 v16, 0
    v_mov_b32 v17, 0
    v_mov_b32 v18, 0
    v_mov_b32 v19, 0
    s_cmp_eq_u32 s23, 0
    s_cbranch_scc0 L_notree
    v_mov_b32 v8, 0
    v_mov_b32 v9, 0
    s_mov_b64 exec, 1
    global_atomic_swap_x2 v[10:11], v34, v[8:9], s[20:21] sc0
    s_mov_b64 exec, -1
    global_load_dwordx4 v[20:23], v31, s[10:11]
    global_load_dwordx4 v[24:27], v31, s[12:13]
    s_lshr_b32 s36, s22, 5
    s_lshl_b32 s36, s36, 1
    v_mov_b32 v28, s36
    global_load_ushort v28, v28, s[14:15]
    s_waitcnt vmcnt(0)
    v_mov_b32 v9, s38
    s_mov_b64 exec, 1
    global_atomic_or v35, v9, s[18:19]
    s_mov_b64 exec, -1
    v_dot2_f32_bf16 v8, v20, v4, 0
    v_dot2_f32_bf16 v8, v21, v5, v8
    v_dot2_f32_bf16 v8, v22, v6, v8
    v_dot2_f32_bf16 v8, v23, v7, v8
    s_nop 2
    v_add_f32_dpp v8, v8, v8 row_ror:8 row_mask:0xf bank_mask:0xf
    s_nop 1
    v_add_f32_dpp v8, v8, v8 row_ror:4 row_mask:0xf bank_mask:0xf
    s_nop 1
    v_add_f32_dpp v8, v8, v8 row_ror:2 row_mask:0xf bank_mask:0xf
    s_nop 1
    v_add_f32_dpp v8, v8, v8 row_ror:1 row_mask:0xf bank_mask:0xf
    v_lshlrev_b32 v28, 16, v28
    v_sub_f32 v28, 1.0, v28
    v_mul_f32 v28, 0xceabfb8f, v28
    v_mul_f32 v8, 0x3e0293ee, v8
    s_mov_b64 exec, 0xffff
    v_add_f32 v2, v8, v28
    v_lshlrev_b32 v12, 16, v24
    v_and_b32 v13, 0xffff0000, v24
    v_lshlrev_b32 v14, 16, v25
    v_and_b32 v15, 0xffff0000, v25
    v_lshlrev_b32 v16, 16, v26
    v_and_b32 v17, 0xffff0000, v26
    v_lshlrev_b32 v18, 16, v27
    v_and_b32 v19, 0xffff0000, v27
    s_mov_b64 exec, 0xf
    v_mov_b32 v3, 1.0
    s_mov_b64 exec, -1
L_notree:
    v_mov_b32 v39, v2
    s_waitcnt vmcnt(6)
    s_mov_b32 s52, 65536
    s_mov_b32 s33, 28
    s_cmp_eq_u32 s62, 0
    s_cselect_b32 s53, 1, 2
L_kloop:
    s_waitcnt vmcnt(5)
    buffer_load_dwordx4 v[68:71], v43, s[24:27], s63 offen offset:2048 nt
    v_dot2_f32_bf16 v8, v44, v4, 0
    v_dot2_f32_bf16 v8, v45, v5, v8
    v_dot2_f32_bf16 v8, v46, v6, v8
    v_dot2_f32_bf16 v8, v47, v7, v8
    s_waitcnt vmcnt(5)
    buffer_load_dwordx4 v[72:75], v43, s[24:27], s63 offen offset:3072 nt
    v_dot2_f32_bf16 v9, v48, v4, 0
    v_dot2_f32_bf16 v9, v49, v5, v9
    v_dot2_f32_bf16 v9, v50, v6, v9
    v_dot2_f32_bf16 v9, v51, v7, v9
    s_waitcnt vmcnt(5)
    buffer_load_dwordx4 v[44:47], v1, s[56:59], s64 offen nt
    v_dot2_f32_bf16 v10, v52, v4, 0
    v_dot2_f32_bf16 v10, v53, v5, v10
    v_dot2_f32_bf16 v10, v54, v6, v10
    v_dot2_f32_bf16 v10, v55, v7, v10
    s_waitcnt vmcnt(5)
    buffer_load_dwordx4 v[48:51], v1, s[56:59], s64 offen offset:1024 nt
    v_dot2_f32_bf16 v11, v56, v4, 0
    v_dot2_f32_bf16 v11, v57, v5, v11
    v_dot2_f32_bf16 v11, v58, v6, v11
    v_dot2_f32_bf16 v11, v59, v7, v11
    v_add_f32_dpp v8, v8, v8 row_ror:8 row_mask:0xf bank_mask:0x3
    v_add_f32_dpp v10, v10, v10 row_ror:8 row_mask:0xf bank_mask:0x3
    s_nop 0
    v_add_f32_dpp v8, v9, v9 row_ror:8 row_mask:0xf bank_mask:0xc
    v_add_f32_dpp v10, v11, v11 row_ror:8 row_mask:0xf bank_mask:0xc
    s_nop 0
    v_add_f32_dpp v8, v8, v8 row_half_mirror row_mask:0xf bank_mask:0x5
    s_nop 1
    v_add_f32_dpp v8, v10, v10 row_half_mirror row_mask:0xf bank_mask:0xa
    s_nop 1
    v_add_f32_dpp v8, v8, v8 quad_perm:[1,0,3,2] row_mask:0xf bank_mask:0xf
    s_nop 1
    v_add_f32_dpp v8, v8, v8 quad_perm:[2,3,0,1] row_mask:0xf bank_mask:0xf
    v_mul_f32 v8, 0x3e0293ee, v8
    v_max_f32 v2, v2, v8
    ds_write_b32 v38, v8 offset:0
    s_waitcnt vmcnt(5)
    buffer_load_dwordx4 v[52:55], v1, s[56:59], s64 offen offset:2048 nt
    v_dot2_f32_bf16 v8, v60, v4, 0
    v_dot2_f32_bf16 v8, v61, v5, v8
    v_dot2_f32_bf16 v8, v62, v6, v8
    v_dot2_f32_bf16 v8, v63, v7, v8
    s_waitcnt vmcnt(5)
    buffer_load_dwordx4 v[56:59], v1, s[56:59], s64 offen offset:3072 nt
    v_dot2_f32_bf16 v9, v64, v4, 0
    v_dot2_f32_bf16 v9, v65, v5, v9
    v_dot2_f32_bf16 v9, v66, v6, v9
    v_dot2_f32_bf16 v9, v67, v7, v9
    s_waitcnt vmcnt(5)
    buffer_load_dwordx4 v[60:63], v43, s[56:59], s64 offen nt
    v_dot2_f32_bf16 v10, v68, v4, 0
    v_dot2_f32_bf16 v10, v69, v5, v10
    v_dot2_f32_bf16 v10, v70, v6, v10
    v_dot2_f32_bf16 v10, v71, v7, v10
    s_waitcnt vmcnt(5)
    buffer_load_dwordx4 v[64:67], v43, s[56:59], s64 offen offset:1024 nt
    v_dot2_f32_bf16 v11, v72, v4, 0
    v_dot2_f32_bf16 v11, v73, v5, v11
    v_dot2_f32_bf16 v11, v74, v6, v11
    v_dot2_f32_bf16 v11, v75, v7, v11
    v_add_f32_dpp v8, v8, v8 row_ror:8 row_mask:0xf bank_mask:0x3
    v_add_f32_dpp v10, v10, v10 row_ror:8 row_mask:0xf bank_mask:0x3
    s_nop 0
    v_add_f32_dpp v8, v9, v9 row_ror:8 row_mask:0xf bank_mask:0xc
    v_add_f32_dpp v10, v11, v11 row_ror:8 row_mask:0xf bank_mask:0xc
    s_nop 0
    v_add_f32_dpp v8, v8, v8 row_half_mirror row_mask:0xf bank_mask:0x5
    s_nop 1
    v_add_f32_dpp v8, v10, v10 row_half_mirror row_mask:0xf bank_mask:0xa
    s_nop 1
    v_add_f32_dpp v8, v8, v8 quad_perm:[1,0,3,2] row_mask:0xf bank_mask:0xf
    s_nop 1
    v_add_f32_dpp v8, v8, v8 quad_perm:[2,3,0,1] row_mask:0xf bank_mask:0xf
    v_mul_f32 v8, 0x3e0293ee, v8
    v_max_f32 v2, v2, v8
    ds_write_b32 v38, v8 offset:256
    v_add_u32 v38, 512, v38
    s_mov_b32 s63, s64
    s_add_u32 s64, s64, s52
    s_sub_u32 s33, s33, 1
    s_cmp_lg_u32 s33, 0
    s_cbranch_scc1 L_kloop
    s_cmp_eq_u32 s53, 2
    s_cbranch_scc0 L_kseg1
    s_mov_b32 s64, s61
    s_mov_b32 s52, 32768
    s_mov_b32 s33, s62
    s_mov_b32 s53, 1
    s_branch L_kloop
L_kseg1:
    s_cmp_eq_u32 s53, 1
    s_cbranch_scc0 L_kdone
    s_mov_b64 s[56:57], s[28:29]
    s_mov_b32 s64, s60
    s_mov_b32 s52, 65536
    s_mov_b32 s33, 1
    s_mov_b32 s53, 0
    s_branch L_kloop
L_kdone:
    v_max_f32_dpp v2, v2, v2 row_ror:4 row_mask:0xf bank_mask:0xf
    s_mul_i32 s36, s3, 16384
    v_lshlrev_b32 v38, 2, v0
    v_max_f32_dpp v2, v2, v2 row_ror:8 row_mask:0xf bank_mask:0xf
    v_add_u32 v38, s36, v38
    v_sub_f32 v29, v39, v2
    v_exp_f32 v29, v29
    s_add_u32 s54, s62, 28
    s_mov_b32 s33, 28
    v_mul_f32 v3, v29, v3
    v_mul_f32 v12, v29, v12
    v_mul_f32 v13, v29, v13
    v_mul_f32 v14, v29, v14
    v_mul_f32 v15, v29, v15
    v_mul_f32 v16, v29, v16
    v_mul_f32 v17, v29, v17
    v_mul_f32 v18, v29, v18
    v_mul_f32 v19, v29, v19
L_vloop:
    ds_read2st64_b32 v[40:41], v38 offset0:0 offset1:1
    s_cmp_eq_u32 s54, 2
    s_cbranch_scc0 L_noflagld
    global_load_dword v36, v35, s[18:19] sc1
L_noflagld:
    s_waitcnt vmcnt(5)
    s_cmp_eq_u32 s54, 1
    s_cbranch_scc0 L_noreq
    v_readfirstlane_b32 s34, v36
    s_nop 0
    s_and_b32 s34, s34, s38
    s_cbranch_scc1 L_flag_ok
    s_mov_b32 s35, 0x100000
L_spin:
    global_load_dword v36, v35, s[18:19] sc1
    s_waitcnt vmcnt(0)
    v_readfirstlane_b32 s34, v36
    s_nop 0
    s_and_b32 s34, s34, s38
    s_cbranch_scc1 L_flag_ok
    s_sub_u32 s35, s35, 1
    s_cmp_lg_u32 s35, 0
    s_cbranch_scc1 L_spin
L_flag_ok:
    s_mov_b64 exec, 1
    global_atomic_add v32, v34, v33, s[20:21] sc0
    s_mov_b64 exec, -1
L_noreq:
    buffer_load_dwordx4 v[68:71], v43, s[28:31], s63 offen offset:2048 nt
    s_waitcnt lgkmcnt(0)
    v_sub_f32 v40, v40, v2
    v_sub_f32 v41, v41, v2
    v_exp_f32 v40, v40
    v_exp_f32 v41, v41
    v_add_u32 v38, 512, v38
    v_add_f32 v28, v40, v41
    v_add_f32 v3, v3, v28
    v_lshlrev_b32 v20, 16, v44
    v_and_b32 v21, 0xffff0000, v44
    v_lshlrev_b32 v22, 16, v45
    v_and_b32 v23, 0xffff0000, v45
    v_lshlrev_b32 v24, 16, v46
    v_and_b32 v25, 0xffff0000, v46
    v_lshlrev_b32 v26, 16, v47
    v_and_b32 v27, 0xffff0000, v47
    v_fmac_f32_dpp v12, v40, v20 row_newbcast:0 row_mask:0xf bank_mask:0xf
    v_fmac_f32_dpp v13, v40, v21 row_newbcast:0 row_mask:0xf bank_mask:0xf
    v_fmac_f32_dpp v14, v40, v22 row_newbcast:0 row_mask:0xf bank_mask:0xf
    v_fmac_f32_dpp v15, v40, v23 row_newbcast:0 row_mask:0xf bank_mask:0xf
    v_fmac_f32_dpp v16, v40, v24 row_newbcast:0 row_mask:0xf bank_mask:0xf
    v_fmac_f32_dpp v17, v40, v25 row_newbcast:0 row_mask:0xf bank_mask:0xf
    v_fmac_f32_dpp v18, v40, v26 row_newbcast:0 row_mask:0xf bank_mask:0xf
    v_fmac_f32_dpp v19, v40, v27 row_newbcast:0 row_mask:0xf bank_mask:0xf
    s_waitcnt vmcnt(5)
    buffer_load_dwordx4 v[72:75], v43, s[28:31], s63 offen offset:3072 nt
    v_lshlrev_b32 v20, 16, v48
    v_and_b32 v21, 0xffff0000, v48
    v_lshlrev_b32 v22, 16, v49
    v_and_b32 v23, 0xffff0000, v49
    v_lshlrev_b32 v24, 16, v50
    v_and_b32 v25, 0xffff0000, v50
    v_lshlrev_b32 v26, 16, v51
    v_and_b32 v27, 0xffff0000, v51
    v_fmac_f32_dpp v12, v40, v20 row_newbcast:8 row_mask:0xf bank_mask:0xf
    v_fmac_f32_dpp v13, v40, v21 row_newbcast:8 row_mask:0xf bank_mask:0xf
    v_fmac_f32_dpp v14, v40, v22 row_newbcast:8 row_mask:0xf bank_mask:0xf
    v_fmac_f32_dpp v15, v40, v23 row_newbcast:8 row_mask:0xf bank_mask:0xf
    v_fmac_f32_dpp v16, v40, v24 row_newbcast:8 row_mask:0xf bank_mask:0xf
    v_fmac_f32_dpp v17, v40, v25 row_newbcast:8 row_mask:0xf bank_mask:0xf
    v_fmac_f32_dpp v18, v40, v26 row_newbcast:8 row_mask:0xf bank_mask:0xf
    v_fmac_f32_dpp v19, v40, v27 row_newbcast:8 row_mask:0xf bank_mask:0xf
    s_waitcnt vmcnt(5)
    buffer_load_dwordx4 v[44:47], v1, s[28:31], s64 offen nt
    v_lshlrev_b32 v20, 16, v52
    v_and_b32 v21, 0xffff0000, v52
    v_lshlrev_b32 v22, 16, v53
    v_and_b32 v23, 0xffff0000, v53
    v_lshlrev_b32 v24, 16, v54
    v_and_b32 v25, 0xffff0000, v54
    v_lshlrev_b32 v26, 16, v55
    v_and_b32 v27, 0xffff0000, v55
    v_fmac_f32_dpp v12, v40, v20 row_newbcast:4 row_mask:0xf bank_mask:0xf
    v_fmac_f32_dpp v13, v40, v21 row_newbcast:4 row_mask:0xf bank_mask:0xf
    v_fmac_f32_dpp v14, v40, v22 row_newbcast:4 row_mask:0xf bank_mask:0xf
    v_fmac_f32_dpp v15, v40, v23 row_newbcast:4 row_mask:0xf bank_mask:0xf
    v_fmac_f32_dpp v16, v40, v24 row_newbcast:4 row_mask:0xf bank_mask:0xf
    v_fmac_f32_dpp v17, v40, v25 row_newbcast:4 row_mask:0xf bank_mask:0xf
    v_fmac_f32_dpp v18, v40, v26 row_newbcast:4 row_mask:0xf bank_mask:0xf
    v_fmac_f32_dpp v19, v40, v27 row_newbcast:4 row_mask:0xf bank_mask:0xf
    s_waitcnt vmcnt(5)
    buffer_load_dwordx4 v[48:51], v1, s[28:31], s64 offen offset:1024 nt
    v_lshlrev_b32 v20, 16, v56
    v_and_b32 v21, 0xffff0000, v56
    v_lshlrev_b32 v22, 16, v57
    v_and_b32 v23, 0xffff0000, v57
    v_lshlrev_b32 v24, 16, v58
    v_and_b32 v25, 0xffff0000, v58
    v_lshlrev_b32 v26, 16, v59
    v_and_b32 v27, 0xffff0000, v59
    v_fmac_f32_dpp v12, v40, v20 row_newbcast:12 row_mask:0xf bank_mask:0xf
    v_fmac_f32_dpp v13, v40, v21 row_newbcast:12 row_mask:0xf bank_mask:0xf
    v_fmac_f32_dpp v14, v40, v22 row_newbcast:12 row_mask:0xf bank_mask:0xf
    v_fmac_f32_dpp v15, v40, v23 row_newbcast:12 row_mask:0xf bank_mask:0xf
    v_fmac_f32_dpp v16, v40, v24 row_newbcast:12 row_mask:0xf bank_mask:0xf
    v_fmac_f32_dpp v17, v40, v25 row_newbcast:12 row_mask:0xf bank_mask:0xf
    v_fmac_f32_dpp v18, v40, v26 row_newbcast:12 row_mask:0xf bank_mask:0xf
    v_fmac_f32_dpp v19, v40, v27 row_newbcast:12 row_mask:0xf bank_mask:0xf
    s_waitcnt vmcnt(5)
    buffer_load_dwordx4 v[52:55], v1, s[28:31], s64 offen offset:2048 nt
    v_lshlrev_b32 v20, 16, v60
    v_and_b32 v21, 0xffff0000, v60
    v_lshlrev_b32 v22, 16, v61
    v_and_b32 v23, 0xffff0000, v61
    v_lshlrev_b32 v24, 16, v62
    v_and_b32 v25, 0xffff0000, v62
    v_lshlrev_b32 v26, 16, v63
    v_and_b32 v27, 0xffff0000, v63
    v_fmac_f32_dpp v12, v41, v20 row_newbcast:0 row_mask:0xf bank_mask:0xf
    v_fmac_f32_dpp v13, v41, v21 row_newbcast:0 row_mask:0xf bank_mask:0xf
    v_fmac_f32_dpp v14, v41, v22 row_newbcast:0 row_mask:0xf bank_mask:0xf
    v_fmac_f32_dpp v15, v41, v23 row_newbcast:0 row_mask:0xf bank_mask:0xf
    v_fmac_f32_dpp v16, v41, v24 row_newbcast:0 row_mask:0xf bank_mask:0xf
    v_fmac_f32_dpp v17, v41, v25 row_newbcast:0 row_mask:0xf bank_mask:0xf
    v_fmac_f32_dpp v18, v41, v26 row_newbcast:0 row_mask:0xf bank_mask:0xf
    v_fmac_f32_dpp v19, v41, v27 row_newbcast:0 row_mask:0xf bank_mask:0xf
    s_waitcnt vmcnt(5)
    buffer_load_dwordx4 v[56:59], v1, s[28:31], s64 offen offset:3072 nt
    v_lshlrev_b32 v20, 16, v64
    v_and_b32 v21, 0xffff0000, v64
    v_lshlrev_b32 v22, 16, v65
    v_and_b32 v23, 0xffff0000, v65
    v_lshlrev_b32 v24, 16, v66
    v_and_b32 v25, 0xffff0000, v66
    v_lshlrev_b32 v26, 16, v67
    v_and_b32 v27, 0xffff0000, v67
    v_fmac_f32_dpp v12, v41, v20 row_newbcast:8 row_mask:0xf bank_mask:0xf
    v_fmac_f32_dpp v13, v41, v21 row_newbcast:8 row_mask:0xf bank_mask:0xf
    v_fmac_f32_dpp v14, v41, v22 row_newbcast:8 row_mask:0xf bank_mask:0xf
    v_fmac_f32_dpp v15, v41, v23 row_newbcast:8 row_mask:0xf bank_mask:0xf
    v_fmac_f32_dpp v16, v41, v24 row_newbcast:8 row_mask:0xf bank_mask:0xf
    v_fmac_f32_dpp v17, v41, v25 row_newbcast:8 row_mask:0xf bank_mask:0xf
    v_fmac_f32_dpp v18, v41, v26 row_newbcast:8 row_mask:0xf bank_mask:0xf
    v_fmac_f32_dpp v19, v41, v27 row_newbcast:8 row_mask:0xf bank_mask:0xf
    s_waitcnt vmcnt(5)
    buffer_load_dwordx4 v[60:63], v43, s[28:31], s64 offen nt
    v_lshlrev_b32 v20, 16, v68
    v_and_b32 v21, 0xffff0000, v68
    v_lshlrev_b32 v22, 16, v69
    v_and_b32 v23, 0xffff0000, v69
    v_lshlrev_b32 v24, 16, v70
    v_and_b32 v25, 0xffff0000, v70
    v_lshlrev_b32 v26, 16, v71
    v_and_b32 v27, 0xffff0000, v71
    v_fmac_f32_dpp v12, v41, v20 row_newbcast:4 row_mask:0xf bank_mask:0xf
    v_fmac_f32_dpp v13, v41, v21 row_newbcast:4 row_mask:0xf bank_mask:0xf
    v_fmac_f32_dpp v14, v41, v22 row_newbcast:4 row_mask:0xf bank_mask:0xf
    v_fmac_f32_dpp v15, v41, v23 row_newbcast:4 row_mask:0xf bank_mask:0xf
    v_fmac_f32_dpp v16, v41, v24 row_newbcast:4 row_mask:0xf bank_mask:0xf
    v_fmac_f32_dpp v17, v41, v25 row_newbcast:4 row_mask:0xf bank_mask:0xf
    v_fmac_f32_dpp v18, v41, v26 row_newbcast:4 row_mask:0xf bank_mask:0xf
    v_fmac_f32_dpp v19, v41, v27 row_newbcast:4 row_mask:0xf bank_mask:0xf
    s_waitcnt vmcnt(5)
    buffer_load_dwordx4 v[64:67], v43, s[28:31], s64 offen offset:1024 nt
    v_lshlrev_b32 v20, 16, v72
    v_and_b32 v21, 0xffff0000, v72
    v_lshlrev_b32 v22, 16, v73
    v_and_b32 v23, 0xffff0000, v73
    v_lshlrev_b32 v24, 16, v74
    v_and_b32 v25, 0xffff0000, v74
    v_lshlrev_b32 v26, 16, v75
    v_and_b32 v27, 0xffff0000, v75
    v_fmac_f32_dpp v12, v41, v20 row_newbcast:12 row_mask:0xf bank_mask:0xf
    v_fmac_f32_dpp v13, v41, v21 row_newbcast:12 row_mask:0xf bank_mask:0xf
    v_fmac_f32_dpp v14, v41, v22 row_newbcast:12 row_mask:0xf bank_mask:0xf
    v_fmac_f32_dpp v15, v41, v23 row_newbcast:12 row_mask:0xf bank_mask:0xf
    v_fmac_f32_dpp v16, v41, v24 row_newbcast:12 row_mask:0xf bank_mask:0xf
    v_fmac_f32_dpp v17, v41, v25 row_newbcast:12 row_mask:0xf bank_mask:0xf
    v_fmac_f32_dpp v18, v41, v26 row_newbcast:12 row_mask:0xf bank_mask:0xf
    v_fmac_f32_dpp v19, v41, v27 row_newbcast:12 row_mask:0xf bank_mask:0xf
    s_mov_b32 s63, s64
    s_add_u32 s64, s64, s52
    s_sub_u32 s54, s54, 1
    s_sub_u32 s33, s33, 1
    s_cmp_lg_u32 s33, 0
    s_cbranch_scc1 L_vloop
    s_cmp_eq_u32 s54, 0
    s_cbranch_scc1 L_vlast
    s_mov_b32 s64, s61
    s_mov_b32 s52, 32768
    s_mov_b32 s33, s54
    s_branch L_vloop
L_vlast:
    ds_read2st64_b32 v[40:41], v38 offset0:0 offset1:1
    s_waitcnt vmcnt(5)
    v_readfirstlane_b32 s37, v32
    s_nop 0
    s_cmp_ge_u32 s37, 20
    s_cbranch_scc1 L_vonly
    s_lshl_b32 s64, s37, 13
    s_add_u32 s64, s64, 1933312
    buffer_load_dwordx4 v[68:71], v43, s[28:31], s63 offen offset:2048 nt
    s_waitcnt lgkmcnt(0)
    v_sub_f32 v40, v40, v2
    v_sub_f32 v41, v41, v2
    v_exp_f32 v40, v40
    v_exp_f32 v41, v41
    v_add_u32 v38, 512, v38
    v_add_f32 v28, v40, v41
    v_add_f32 v3, v3, v28
    v_lshlrev_b32 v20, 16, v44
    v_and_b32 v21, 0xffff0000, v44
    v_lshlrev_b32 v22, 16, v45
    v_and_b32 v23, 0xffff0000, v45
    v_lshlrev_b32 v24, 16, v46
    v_and_b32 v25, 0xffff0000, v46
    v_lshlrev_b32 v26, 16, v47
    v_and_b32 v27, 0xffff0000, v47
    v_fmac_f32_dpp v12, v40, v20 row_newbcast:0 row_mask:0xf bank_mask:0xf
    v_fmac_f32_dpp v13, v40, v21 row_newbcast:0 row_mask:0xf bank_mask:0xf
    v_fmac_f32_dpp v14, v40, v22 row_newbcast:0 row_mask:0xf bank_mask:0xf
    v_fmac_f32_dpp v15, v40, v23 row_newbcast:0 row_mask:0xf bank_mask:0xf
    v_fmac_f32_dpp v16, v40, v24 row_newbcast:0 row_mask:0xf bank_mask:0xf
    v_fmac_f32_dpp v17, v40, v25 row_newbcast:0 row_mask:0xf bank_mask:0xf
    v_fmac_f32_dpp v18, v40, v26 row_newbcast:0 row_mask:0xf bank_mask:0xf
    v_fmac_f32_dpp v19, v40, v27 row_newbcast:0 row_mask:0xf bank_mask:0xf
    s_waitcnt vmcnt(5)
    buffer_load_dwordx4 v[72:75], v43, s[28:31], s63 offen offset:3072 nt
    v_lshlrev_b32 v20, 16, v48
    v_and_b32 v21, 0xffff0000, v48
    v_lshlrev_b32 v22, 16, v49
    v_and_b32 v23, 0xffff0000, v49
    v_lshlrev_b32 v24, 16, v50
    v_and_b32 v25, 0xffff0000, v50
    v_lshlrev_b32 v26, 16, v51
    v_and_b32 v27, 0xffff0000, v51
    v_fmac_f32_dpp v12, v40, v20 row_newbcast:8 row_mask:0xf bank_mask:0xf
    v_fmac_f32_dpp v13, v40, v21 row_newbcast:8 row_mask:0xf bank_mask:0xf
    v_fmac_f32_dpp v14, v40, v22 row_newbcast:8 row_mask:0xf bank_mask:0xf
    v_fmac_f32_dpp v15, v40, v23 row_newbcast:8 row_mask:0xf bank_mask:0xf
    v_fmac_f32_dpp v16, v40, v24 row_newbcast:8 row_mask:0xf bank_mask:0xf
    v_fmac_f32_dpp v17, v40, v25 row_newbcast:8 row_mask:0xf bank_mask:0xf
    v_fmac_f32_dpp v18, v40, v26 row_newbcast:8 row_mask:0xf bank_mask:0xf
    v_fmac_f32_dpp v19, v40, v27 row_newbcast:8 row_mask:0xf bank_mask:0xf
    s_waitcnt vmcnt(5)
    buffer_load_dwordx4 v[44:47], v1, s[24:27], s64 offen nt
    v_lshlrev_b32 v20, 16, v52
    v_and_b32 v21, 0xffff0000, v52
    v_lshlrev_b32 v22, 16, v53
    v_and_b32 v23, 0xffff0000, v53
    v_lshlrev_b32 v24, 16, v54
    v_and_b32 v25, 0xffff0000, v54
    v_lshlrev_b32 v26, 16, v55
    v_and_b32 v27, 0xffff0000, v55
    v_fmac_f32_dpp v12, v40, v20 row_newbcast:4 row_mask:0xf bank_mask:0xf
    v_fmac_f32_dpp v13, v40, v21 row_newbcast:4 row_mask:0xf bank_mask:0xf
    v_fmac_f32_dpp v14, v40, v22 row_newbcast:4 row_mask:0xf bank_mask:0xf
    v_fmac_f32_dpp v15, v40, v23 row_newbcast:4 row_mask:0xf bank_mask:0xf
    v_fmac_f32_dpp v16, v40, v24 row_newbcast:4 row_mask:0xf bank_mask:0xf
    v_fmac_f32_dpp v17, v40, v25 row_newbcast:4 row_mask:0xf bank_mask:0xf
    v_fmac_f32_dpp v18, v40, v26 row_newbcast:4 row_mask:0xf bank_mask:0xf
    v_fmac_f32_dpp v19, v40, v27 row_newbcast:4 row_mask:0xf bank_mask:0xf
    s_waitcnt vmcnt(5)
    buffer_load_dwordx4 v[48:51], v1, s[24:27], s64 offen offset:1024 nt
    v_lshlrev_b32 v20, 16, v56
    v_and_b32 v21, 0xffff0000, v56
    v_lshlrev_b32 v22, 16, v57
    v_and_b32 v23, 0xffff0000, v57
    v_lshlrev_b32 v24, 16, v58
    v_and_b32 v25, 0xffff0000, v58
    v_lshlrev_b32 v26, 16, v59
    v_and_b32 v27, 0xffff0000, v59
    v_fmac_f32_dpp v12, v40, v20 row_newbcast:12 row_mask:0xf bank_mask:0xf
    v_fmac_f32_dpp v13, v40, v21 row_newbcast:12 row_mask:0xf bank_mask:0xf
    v_fmac_f32_dpp v14, v40, v22 row_newbcast:12 row_mask:0xf bank_mask:0xf
    v_fmac_f32_dpp v15, v40, v23 row_newbcast:12 row_mask:0xf bank_mask:0xf
    v_fmac_f32_dpp v16, v40, v24 row_newbcast:12 row_mask:0xf bank_mask:0xf
    v_fmac_f32_dpp v17, v40, v25 row_newbcast:12 row_mask:0xf bank_mask:0xf
    v_fmac_f32_dpp v18, v40, v26 row_newbcast:12 row_mask:0xf bank_mask:0xf
    v_fmac_f32_dpp v19, v40, v27 row_newbcast:12 row_mask:0xf bank_mask:0xf
    s_waitcnt vmcnt(5)
    buffer_load_dwordx4 v[52:55], v1, s[24:27], s64 offen offset:2048 nt
    v_lshlrev_b32 v20, 16, v60
    v_and_b32 v21, 0xffff0000, v60
    v_lshlrev_b32 v22, 16, v61
    v_and_b32 v23, 0xffff0000, v61
    v_lshlrev_b32 v24, 16, v62
    v_and_b32 v25, 0xffff0000, v62
    v_lshlrev_b32 v26, 16, v63
    v_and_b32 v27, 0xffff0000, v63
    v_fmac_f32_dpp v12, v41, v20 row_newbcast:0 row_mask:0xf bank_mask:0xf
    v_fmac_f32_dpp v13, v41, v21 row_newbcast:0 row_mask:0xf bank_mask:0xf
    v_fmac_f32_dpp v14, v41, v22 row_newbcast:0 row_mask:0xf bank_mask:0xf
    v_fmac_f32_dpp v15, v41, v23 row_newbcast:0 row_mask:0xf bank_mask:0xf
    v_fmac_f32_dpp v16, v41, v24 row_newbcast:0 row_mask:0xf bank_mask:0xf
    v_fmac_f32_dpp v17, v41, v25 row_newbcast:0 row_mask:0xf bank_mask:0xf
    v_fmac_f32_dpp v18, v41, v26 row_newbcast:0 row_mask:0xf bank_mask:0xf
    v_fmac_f32_dpp v19, v41, v27 row_newbcast:0 row_mask:0xf bank_mask:0xf
    s_waitcnt vmcnt(5)
    buffer_load_dwordx4 v[56:59], v1, s[24:27], s64 offen offset:3072 nt
    v_lshlrev_b32 v20, 16, v64
    v_and_b32 v21, 0xffff0000, v64
    v_lshlrev_b32 v22, 16, v65
    v_and_b32 v23, 0xffff0000, v65
    v_lshlrev_b32 v24, 16, v66
    v_and_b32 v25, 0xffff0000, v66
    v_lshlrev_b32 v26, 16, v67
    v_and_b32 v27, 0xffff0000, v67
    v_fmac_f32_dpp v12, v41, v20 row_newbcast:8 row_mask:0xf bank_mask:0xf
    v_fmac_f32_dpp v13, v41, v21 row_newbcast:8 row_mask:0xf bank_mask:0xf
    v_fmac_f32_dpp v14, v41, v22 row_newbcast:8 row_mask:0xf bank_mask:0xf
    v_fmac_f32_dpp v15, v41, v23 row_newbcast:8 row_mask:0xf bank_mask:0xf
    v_fmac_f32_dpp v16, v41, v24 row_newbcast:8 row_mask:0xf bank_mask:0xf
    v_fmac_f32_dpp v17, v41, v25 row_newbcast:8 row_mask:0xf bank_mask:0xf
    v_fmac_f32_dpp v18, v41, v26 row_newbcast:8 row_mask:0xf bank_mask:0xf
    v_fmac_f32_dpp v19, v41, v27 row_newbcast:8 row_mask:0xf bank_mask:0xf
    s_waitcnt vmcnt(5)
    buffer_load_dwordx4 v[60:63], v1, s[28:31], s64 offen nt
    v_lshlrev_b32 v20, 16, v68
    v_and_b32 v21, 0xffff0000, v68
    v_lshlrev_b32 v22, 16, v69
    v_and_b32 v23, 0xffff0000, v69
    v_lshlrev_b32 v24, 16, v70
    v_and_b32 v25, 0xffff0000, v70
    v_lshlrev_b32 v26, 16, v71
    v_and_b32 v27, 0xffff0000, v71
    v_fmac_f32_dpp v12, v41, v20 row_newbcast:4 row_mask:0xf bank_mask:0xf
    v_fmac_f32_dpp v13, v41, v21 row_newbcast:4 row_mask:0xf bank_mask:0xf
    v_fmac_f32_dpp v14, v41, v22 row_newbcast:4 row_mask:0xf bank_mask:0xf
    v_fmac_f32_dpp v15, v41, v23 row_newbcast:4 row_mask:0xf bank_mask:0xf
    v_fmac_f32_dpp v16, v41, v24 row_newbcast:4 row_mask:0xf bank_mask:0xf
    v_fmac_f32_dpp v17, v41, v25 row_newbcast:4 row_mask:0xf bank_mask:0xf
    v_fmac_f32_dpp v18, v41, v26 row_newbcast:4 row_mask:0xf bank_mask:0xf
    v_fmac_f32_dpp v19, v41, v27 row_newbcast:4 row_mask:0xf bank_mask:0xf
    s_waitcnt vmcnt(5)
    buffer_load_dwordx4 v[64:67], v1, s[28:31], s64 offen offset:1024 nt
    v_lshlrev_b32 v20, 16, v72
    v_and_b32 v21, 0xffff0000, v72
    v_lshlrev_b32 v22, 16, v73
    v_and_b32 v23, 0xffff0000, v73
    v_lshlrev_b32 v24, 16, v74
    v_and_b32 v25, 0xffff0000, v74
    v_lshlrev_b32 v26, 16, v75
    v_and_b32 v27, 0xffff0000, v75
    v_fmac_f32_dpp v12, v41, v20 row_newbcast:12 row_mask:0xf bank_mask:0xf
    v_fmac_f32_dpp v13, v41, v21 row_newbcast:12 row_mask:0xf bank_mask:0xf
    v_fmac_f32_dpp v14, v41, v22 row_newbcast:12 row_mask:0xf bank_mask:0xf
    v_fmac_f32_dpp v15, v41, v23 row_newbcast:12 row_mask:0xf bank_mask:0xf
    v_fmac_f32_dpp v16, v41, v24 row_newbcast:12 row_mask:0xf bank_mask:0xf
    v_fmac_f32_dpp v17, v41, v25 row_newbcast:12 row_mask:0xf bank_mask:0xf
    v_fmac_f32_dpp v18, v41, v26 row_newbcast:12 row_mask:0xf bank_mask:0xf
    v_fmac_f32_dpp v19, v41, v27 row_newbcast:12 row_mask:0xf bank_mask:0xf
    s_mov_b32 s63, s64
L_dloop:
    s_add_u32 s64, s63, 4096
    s_waitcnt vmcnt(5)
    s_mov_b64 exec, 1
    global_atomic_add v32, v34, v33, s[20:21] sc0
    s_mov_b64 exec, -1
    buffer_load_dwordx4 v[68:71], v1, s[28:31], s63 offen offset:2048 nt
    v_dot2_f32_bf16 v8, v44, v4, 0
    v_dot2_f32_bf16 v8, v45, v5, v8
    v_dot2_f32_bf16 v8, v46, v6, v8
    v_dot2_f32_bf16 v8, v47, v7, v8
    s_waitcnt vmcnt(6)
    buffer_load_dwordx4 v[72:75], v1, s[28:31], s63 offen offset:3072 nt
    v_dot2_f32_bf16 v9, v48, v4, 0
    v_dot2_f32_bf16 v9, v49, v5, v9
    v_dot2_f32_bf16 v9, v50, v6, v9
    v_dot2_f32_bf16 v9, v51, v7, v9
    s_waitcnt vmcnt(6)
    buffer_load_dwordx4 v[44:47], v1, s[24:27], s64 offen nt
    v_dot2_f32_bf16 v10, v52, v4, 0
    v_dot2_f32_bf16 v10, v53, v5, v10
    v_dot2_f32_bf16 v10, v54, v6, v10
    v_dot2_f32_bf16 v10, v55, v7, v10
    s_waitcnt vmcnt(6)
    buffer_load_dwordx4 v[48:51], v1, s[24:27], s64 offen offset:1024 nt
    v_dot2_f32_bf16 v11, v56, v4, 0
    v_dot2_f32_bf16 v11, v57, v5, v11
    v_dot2_f32_bf16 v11, v58, v6, v11
    v_dot2_f32_bf16 v11, v59, v7, v11
    v_add_f32_dpp v8, v8, v8 row_ror:8 row_mask:0xf bank_mask:0x3
    v_add_f32_dpp v10, v10, v10 row_ror:8 row_mask:0xf bank_mask:0x3
    s_nop 0
    v_add_f32_dpp v8, v9, v9 row_ror:8 row_mask:0xf bank_mask:0xc
    v_add_f32_dpp v10, v11, v11 row_ror:8 row_mask:0xf bank_mask:0xc
    s_nop 0
    v_add_f32_dpp v8, v8, v8 row_half_mirror row_mask:0xf bank_mask:0x5
    s_nop 1
    v_add_f32_dpp v8, v10, v10 row_half_mirror row_mask:0xf bank_mask:0xa
    s_nop 1
    v_add_f32_dpp v8, v8, v8 quad_perm:[1,0,3,2] row_mask:0xf bank_mask:0xf
    s_nop 1
    v_add_f32_dpp v8, v8, v8 quad_perm:[2,3,0,1] row_mask:0xf bank_mask:0xf
    v_mul_f32 v8, 0x3e0293ee, v8
    s_nop 1
    v_max_f32_dpp v28, v8, v8 row_ror:4 row_mask:0xf bank_mask:0xf
    s_nop 1
    v_max_f32_dpp v28, v28, v28 row_ror:8 row_mask:0xf bank_mask:0xf
    v_max_f32 v28, v2, v28
    v_sub_f32 v29, v2, v28
    v_sub_f32 v30, v8, v28
    v_exp_f32 v29, v29
    v_exp_f32 v30, v30
    v_mov_b32 v2, v28
    v_mul_f32 v12, v29, v12
    v_mul_f32 v13, v29, v13
    v_mul_f32 v14, v29, v14
    v_mul_f32 v15, v29, v15
    v_mul_f32 v16, v29, v16
    v_mul_f32 v17, v29, v17
    v_mul_f32 v18, v29, v18
    v_mul_f32 v19, v29, v19
    v_fma_f32 v3, v3, v29, v30
    s_waitcnt vmcnt(6)
    buffer_load_dwordx4 v[52:55], v1, s[24:27], s64 offen offset:2048 nt
    v_lshlrev_b32 v20, 16, v60
    v_and_b32 v21, 0xffff0000, v60
    v_lshlrev_b32 v22, 16, v61
    v_and_b32 v23, 0xffff0000, v61
    v_lshlrev_b32 v24, 16, v62
    v_and_b32 v25, 0xffff0000, v62
    v_lshlrev_b32 v26, 16, v63
    v_and_b32 v27, 0xffff0000, v63
    v_fmac_f32_dpp v12, v30, v20 row_newbcast:0 row_mask:0xf bank_mask:0xf
    v_fmac_f32_dpp v13, v30, v21 row_newbcast:0 row_mask:0xf bank_mask:0xf
    v_fmac_f32_dpp v14, v30, v22 row_newbcast:0 row_mask:0xf bank_mask:0xf
    v_fmac_f32_dpp v15, v30, v23 row_newbcast:0 row_mask:0xf bank_mask:0xf
    v_fmac_f32_dpp v16, v30, v24 row_newbcast:0 row_mask:0xf bank_mask:0xf
    v_fmac_f32_dpp v17, v30, v25 row_newbcast:0 row_mask:0xf bank_mask:0xf
    v_fmac_f32_dpp v18, v30, v26 row_newbcast:0 row_mask:0xf bank_mask:0xf
    v_fmac_f32_dpp v19, v30, v27 row_newbcast:0 row_mask:0xf bank_mask:0xf
    s_waitcnt vmcnt(6)
    buffer_load_dwordx4 v[56:59], v1, s[24:27], s64 offen offset:3072 nt
    v_lshlrev_b32 v20, 16, v64
    v_and_b32 v21, 0xffff0000, v64
    v_lshlrev_b32 v22, 16, v65
    v_and_b32 v23, 0xffff0000, v65
    v_lshlrev_b32 v24, 16, v66
    v_and_b32 v25, 0xffff0000, v66
    v_lshlrev_b32 v26, 16, v67
    v_and_b32 v27, 0xffff0000, v67
    v_fmac_f32_dpp v12, v30, v20 row_newbcast:8 row_mask:0xf bank_mask:0xf
    v_fmac_f32_dpp v13, v30, v21 row_newbcast:8 row_mask:0xf bank_mask:0xf
    v_fmac_f32_dpp v14, v30, v22 row_newbcast:8 row_mask:0xf bank_mask:0xf
    v_fmac_f32_dpp v15, v30, v23 row_newbcast:8 row_mask:0xf bank_mask:0xf
    v_fmac_f32_dpp v16, v30, v24 row_newbcast:8 row_mask:0xf bank_mask:0xf
    v_fmac_f32_dpp v17, v30, v25 row_newbcast:8 row_mask:0xf bank_mask:0xf
    v_fmac_f32_dpp v18, v30, v26 row_newbcast:8 row_mask:0xf bank_mask:0xf
    v_fmac_f32_dpp v19, v30, v27 row_newbcast:8 row_mask:0xf bank_mask:0xf
    s_waitcnt vmcnt(5)
    buffer_load_dwordx4 v[60:63], v1, s[28:31], s64 offen nt
    v_lshlrev_b32 v20, 16, v68
    v_and_b32 v21, 0xffff0000, v68
    v_lshlrev_b32 v22, 16, v69
    v_and_b32 v23, 0xffff0000, v69
    v_lshlrev_b32 v24, 16, v70
    v_and_b32 v25, 0xffff0000, v70
    v_lshlrev_b32 v26, 16, v71
    v_and_b32 v27, 0xffff0000, v71
    v_fmac_f32_dpp v12, v30, v20 row_newbcast:4 row_mask:0xf bank_mask:0xf
    v_fmac_f32_dpp v13, v30, v21 row_newbcast:4 row_mask:0xf bank_mask:0xf
    v_fmac_f32_dpp v14, v30, v22 row_newbcast:4 row_mask:0xf bank_mask:0xf
    v_fmac_f32_dpp v15, v30, v23 row_newbcast:4 row_mask:0xf bank_mask:0xf
    v_fmac_f32_dpp v16, v30, v24 row_newbcast:4 row_mask:0xf bank_mask:0xf
    v_fmac_f32_dpp v17, v30, v25 row_newbcast:4 row_mask:0xf bank_mask:0xf
    v_fmac_f32_dpp v18, v30, v26 row_newbcast:4 row_mask:0xf bank_mask:0xf
    v_fmac_f32_dpp v19, v30, v27 row_newbcast:4 row_mask:0xf bank_mask:0xf
    s_waitcnt vmcnt(5)
    buffer_load_dwordx4 v[64:67], v1, s[28:31], s64 offen offset:1024 nt
    v_lshlrev_b32 v20, 16, v72
    v_and_b32 v21, 0xffff0000, v72
    v_lshlrev_b32 v22, 16, v73
    v_and_b32 v23, 0xffff0000, v73
    v_lshlrev_b32 v24, 16, v74
    v_and_b32 v25, 0xffff0000, v74
    v_lshlrev_b32 v26, 16, v75
    v_and_b32 v27, 0xffff0000, v75
    v_fmac_f32_dpp v12, v30, v20 row_newbcast:12 row_mask:0xf bank_mask:0xf
    v_fmac_f32_dpp v13, v30, v21 row_newbcast:12 row_mask:0xf bank_mask:0xf
    v_fmac_f32_dpp v14, v30, v22 row_newbcast:12 row_mask:0xf bank_mask:0xf
    v_fmac_f32_dpp v15, v30, v23 row_newbcast:12 row_mask:0xf bank_mask:0xf
    v_fmac_f32_dpp v16, v30, v24 row_newbcast:12 row_mask:0xf bank_mask:0xf
    v_fmac_f32_dpp v17, v30, v25 row_newbcast:12 row_mask:0xf bank_mask:0xf
    v_fmac_f32_dpp v18, v30, v26 row_newbcast:12 row_mask:0xf bank_mask:0xf
    v_fmac_f32_dpp v19, v30, v27 row_newbcast:12 row_mask:0xf bank_mask:0xf
    s_mov_b32 s63, s64
    s_waitcnt vmcnt(5)
    v_readfirstlane_b32 s37, v32
    s_nop 0
    s_cmp_ge_u32 s37, 20
    s_cbranch_scc1 L_drain
    s_lshl_b32 s64, s37, 13
    s_add_u32 s64, s64, 1933312
    buffer_load_dwordx4 v[68:71], v1, s[28:31], s63 offen offset:2048 nt
    v_dot2_f32_bf16 v8, v44, v4, 0
    v_dot2_f32_bf16 v8, v45, v5, v8
    v_dot2_f32_bf16 v8, v46, v6, v8
    v_dot2_f32_bf16 v8, v47, v7, v8
    s_waitcnt vmcnt(5)
    buffer_load_dwordx4 v[72:75], v1, s[28:31], s63 offen offset:3072 nt
    v_dot2_f32_bf16 v9, v48, v4, 0
    v_dot2_f32_bf16 v9, v49, v5, v9
    v_dot2_f32_bf16 v9, v50, v6, v9
    v_dot2_f32_bf16 v9, v51, v7, v9
    s_waitcnt vmcnt(5)
    buffer_load_dwordx4 v[44:47], v1, s[24:27], s64 offen nt
    v_dot2_f32_bf16 v10, v52, v4, 0
    v_dot2_f32_bf16 v10, v53, v5, v10
    v_dot2_f32_bf16 v10, v54, v6, v10
    v_dot2_f32_bf16 v10, v55, v7, v10
    s_waitcnt vmcnt(5)
    buffer_load_dwordx4 v[48:51], v1, s[24:27], s64 offen offset:1024 nt
    v_dot2_f32_bf16 v11, v56, v4, 0
    v_dot2_f32_bf16 v11, v57, v5, v11
    v_dot2_f32_bf16 v11, v58, v6, v11
    v_dot2_f32_bf16 v11, v59, v7, v11
    v_add_f32_dpp v8, v8, v8 row_ror:8 row_mask:0xf bank_mask:0x3
    v_add_f32_dpp v10, v10, v10 row_ror:8 row_mask:0xf bank_mask:0x3
    s_nop 0
    v_add_f32_dpp v8, v9, v9 row_ror:8 row_mask:0xf bank_mask:0xc
    v_add_f32_dpp v10, v11, v11 row_ror:8 row_mask:0xf bank_mask:0xc
    s_nop 0
    v_add_f32_dpp v8, v8, v8 row_half_mirror row_mask:0xf bank_mask:0x5
    s_nop 1
    v_add_f32_dpp v8, v10, v10 row_half_mirror row_mask:0xf bank_mask:0xa
    s_nop 1
    v_add_f32_dpp v8, v8, v8 quad_perm:[1,0,3,2] row_mask:0xf bank_mask:0xf
    s_nop 1
    v_add_f32_dpp v8, v8, v8 quad_perm:[2,3,0,1] row_mask:0xf bank_mask:0xf
    v_mul_f32 v8, 0x3e0293ee, v8
    s_nop 1
    v_max_f32_dpp v28, v8, v8 row_ror:4 row_mask:0xf bank_mask:0xf
    s_nop 1
    v_max_f32_dpp v28, v28, v28 row_ror:8 row_mask:0xf bank_mask:0xf
    v_max_f32 v28, v2, v28
    v_sub_f32 v29, v2, v28
    v_sub_f32 v30, v8, v28
    v_exp_f32 v29, v29
    v_exp_f32 v30, v30
    v_mov_b32 v2, v28
    v_mul_f32 v12, v29, v12
    v_mul_f32 v13, v29, v13
    v_mul_f32 v14, v29, v14
    v_mul_f32 v15, v29, v15
    v_mul_f32 v16, v29, v16
    v_mul_f32 v17, v29, v17
    v_mul_f32 v18, v29, v18
    v_mul_f32 v19, v29, v19
    v_fma_f32 v3, v3, v29, v30
    s_waitcnt vmcnt(5)
    buffer_load_dwordx4 v[52:55], v1, s[24:27], s64 offen offset:2048 nt
    v_lshlrev_b32 v20, 16, v60
    v_and_b32 v21, 0xffff0000, v60
    v_lshlrev_b32 v22, 16, v61
    v_and_b32 v23, 0xffff0000, v61
    v_lshlrev_b32 v24, 16, v62
    v_and_b32 v25, 0xffff0000, v62
    v_lshlrev_b32 v26, 16, v63
    v_and_b32 v27, 0xffff0000, v63
    v_fmac_f32_dpp v12, v30, v20 row_newbcast:0 row_mask:0xf bank_mask:0xf
    v_fmac_f32_dpp v13, v30, v21 row_newbcast:0 row_mask:0xf bank_mask:0xf
    v_fmac_f32_dpp v14, v30, v22 row_newbcast:0 row_mask:0xf bank_mask:0xf
    v_fmac_f32_dpp v15, v30, v23 row_newbcast:0 row_mask:0xf bank_mask:0xf
    v_fmac_f32_dpp v16, v30, v24 row_newbcast:0 row_mask:0xf bank_mask:0xf
    v_fmac_f32_dpp v17, v30, v25 row_newbcast:0 row_mask:0xf bank_mask:0xf
    v_fmac_f32_dpp v18, v30, v26 row_newbcast:0 row_mask:0xf bank_mask:0xf
    v_fmac_f32_dpp v19, v30, v27 row_newbcast:0 row_mask:0xf bank_mask:0xf
    s_waitcnt vmcnt(5)
    buffer_load_dwordx4 v[56:59], v1, s[24:27], s64 offen offset:3072 nt
    v_lshlrev_b32 v20, 16, v64
    v_and_b32 v21, 0xffff0000, v64
    v_lshlrev_b32 v22, 16, v65
    v_and_b32 v23, 0xffff0000, v65
    v_lshlrev_b32 v24, 16, v66
    v_and_b32 v25, 0xffff0000, v66
    v_lshlrev_b32 v26, 16, v67
    v_and_b32 v27, 0xffff0000, v67
    v_fmac_f32_dpp v12, v30, v20 row_newbcast:8 row_mask:0xf bank_mask:0xf
    v_fmac_f32_dpp v13, v30, v21 row_newbcast:8 row_mask:0xf bank_mask:0xf
    v_fmac_f32_dpp v14, v30, v22 row_newbcast:8 row_mask:0xf bank_mask:0xf
    v_fmac_f32_dpp v15, v30, v23 row_newbcast:8 row_mask:0xf bank_mask:0xf
    v_fmac_f32_dpp v16, v30, v24 row_newbcast:8 row_mask:0xf bank_mask:0xf
    v_fmac_f32_dpp v17, v30, v25 row_newbcast:8 row_mask:0xf bank_mask:0xf
    v_fmac_f32_dpp v18, v30, v26 row_newbcast:8 row_mask:0xf bank_mask:0xf
    v_fmac_f32_dpp v19, v30, v27 row_newbcast:8 row_mask:0xf bank_mask:0xf
    s_waitcnt vmcnt(5)
    buffer_load_dwordx4 v[60:63], v1, s[28:31], s64 offen nt
    v_lshlrev_b32 v20, 16, v68
    v_and_b32 v21, 0xffff0000, v68
    v_lshlrev_b32 v22, 16, v69
    v_and_b32 v23, 0xffff0000, v69
    v_lshlrev_b32 v24, 16, v70
    v_and_b32 v25, 0xffff0000, v70
    v_lshlrev_b32 v26, 16, v71
    v_and_b32 v27, 0xffff0000, v71
    v_fmac_f32_dpp v12, v30, v20 row_newbcast:4 row_mask:0xf bank_mask:0xf
    v_fmac_f32_dpp v13, v30, v21 row_newbcast:4 row_mask:0xf bank_mask:0xf
    v_fmac_f32_dpp v14, v30, v22 row_newbcast:4 row_mask:0xf bank_mask:0xf
    v_fmac_f32_dpp v15, v30, v23 row_newbcast:4 row_mask:0xf bank_mask:0xf
    v_fmac_f32_dpp v16, v30, v24 row_newbcast:4 row_mask:0xf bank_mask:0xf
    v_fmac_f32_dpp v17, v30, v25 row_newbcast:4 row_mask:0xf bank_mask:0xf
    v_fmac_f32_dpp v18, v30, v26 row_newbcast:4 row_mask:0xf bank_mask:0xf
    v_fmac_f32_dpp v19, v30, v27 row_newbcast:4 row_mask:0xf bank_mask:0xf
    s_waitcnt vmcnt(5)
    buffer_load_dwordx4 v[64:67], v1, s[28:31], s64 offen offset:1024 nt
    v_lshlrev_b32 v20, 16, v72
    v_and_b32 v21, 0xffff0000, v72
    v_lshlrev_b32 v22, 16, v73
    v_and_b32 v23, 0xffff0000, v73
    v_lshlrev_b32 v24, 16, v74
    v_and_b32 v25, 0xffff0000, v74
    v_lshlrev_b32 v26, 16, v75
    v_and_b32 v27, 0xffff0000, v75
    v_fmac_f32_dpp v12, v30, v20 row_newbcast:12 row_mask:0xf bank_mask:0xf
    v_fmac_f32_dpp v13, v30, v21 row_newbcast:12 row_mask:0xf bank_mask:0xf
    v_fmac_f32_dpp v14, v30, v22 row_newbcast:12 row_mask:0xf bank_mask:0xf
    v_fmac_f32_dpp v15, v30, v23 row_newbcast:12 row_mask:0xf bank_mask:0xf
    v_fmac_f32_dpp v16, v30, v24 row_newbcast:12 row_mask:0xf bank_mask:0xf
    v_fmac_f32_dpp v17, v30, v25 row_newbcast:12 row_mask:0xf bank_mask:0xf
    v_fmac_f32_dpp v18, v30, v26 row_newbcast:12 row_mask:0xf bank_mask:0xf
    v_fmac_f32_dpp v19, v30, v27 row_newbcast:12 row_mask:0xf bank_mask:0xf
    s_mov_b32 s63, s64
    s_branch L_dloop
L_vonly:
    buffer_load_dwordx4 v[68:71], v43, s[28:31], s63 offen offset:2048 nt
    s_waitcnt lgkmcnt(0)
    v_sub_f32 v40, v40, v2
    v_sub_f32 v41, v41, v2
    v_exp_f32 v40, v40
    v_exp_f32 v41, v41
    v_add_u32 v38, 512, v38
    v_add_f32 v28, v40, v41
    v_add_f32 v3, v3, v28
    v_lshlrev_b32 v20, 16, v44
    v_and_b32 v21, 0xffff0000, v44
    v_lshlrev_b32 v22, 16, v45
    v_and_b32 v23, 0xffff0000, v45
    v_lshlrev_b32 v24, 16, v46
    v_and_b32 v25, 0xffff0000, v46
    v_lshlrev_b32 v26, 16, v47
    v_and_b32 v27, 0xffff0000, v47
    v_fmac_f32_dpp v12, v40, v20 row_newbcast:0 row_mask:0xf bank_mask:0xf
    v_fmac_f32_dpp v13, v40, v21 row_newbcast:0 row_mask:0xf bank_mask:0xf
    v_fmac_f32_dpp v14, v40, v22 row_newbcast:0 row_mask:0xf bank_mask:0xf
    v_fmac_f32_dpp v15, v40, v23 row_newbcast:0 row_mask:0xf bank_mask:0xf
    v_fmac_f32_dpp v16, v40, v24 row_newbcast:0 row_mask:0xf bank_mask:0xf
    v_fmac_f32_dpp v17, v40, v25 row_newbcast:0 row_mask:0xf bank_mask:0xf
    v_fmac_f32_dpp v18, v40, v26 row_newbcast:0 row_mask:0xf bank_mask:0xf
    v_fmac_f32_dpp v19, v40, v27 row_newbcast:0 row_mask:0xf bank_mask:0xf
    s_waitcnt vmcnt(5)
    buffer_load_dwordx4 v[72:75], v43, s[28:31], s63 offen offset:3072 nt
    v_lshlrev_b32 v20, 16, v48
    v_and_b32 v21, 0xffff0000, v48
    v_lshlrev_b32 v22, 16, v49
    v_and_b32 v23, 0xffff0000, v49
    v_lshlrev_b32 v24, 16, v50
    v_and_b32 v25, 0xffff0000, v50
    v_lshlrev_b32 v26, 16, v51
    v_and_b32 v27, 0xffff0000, v51
    v_fmac_f32_dpp v12, v40, v20 row_newbcast:8 row_mask:0xf bank_mask:0xf
    v_fmac_f32_dpp v13, v40, v21 row_newbcast:8 row_mask:0xf bank_mask:0xf
    v_fmac_f32_dpp v14, v40, v22 row_newbcast:8 row_mask:0xf bank_mask:0xf
    v_fmac_f32_dpp v15, v40, v23 row_newbcast:8 row_mask:0xf bank_mask:0xf
    v_fmac_f32_dpp v16, v40, v24 row_newbcast:8 row_mask:0xf bank_mask:0xf
    v_fmac_f32_dpp v17, v40, v25 row_newbcast:8 row_mask:0xf bank_mask:0xf
    v_fmac_f32_dpp v18, v40, v26 row_newbcast:8 row_mask:0xf bank_mask:0xf
    v_fmac_f32_dpp v19, v40, v27 row_newbcast:8 row_mask:0xf bank_mask:0xf
    s_waitcnt vmcnt(5)
    v_lshlrev_b32 v20, 16, v52
    v_and_b32 v21, 0xffff0000, v52
    v_lshlrev_b32 v22, 16, v53
    v_and_b32 v23, 0xffff0000, v53
    v_lshlrev_b32 v24, 16, v54
    v_and_b32 v25, 0xffff0000, v54
    v_lshlrev_b32 v26, 16, v55
    v_and_b32 v27, 0xffff0000, v55
    v_fmac_f32_dpp v12, v40, v20 row_newbcast:4 row_mask:0xf bank_mask:0xf
    v_fmac_f32_dpp v13, v40, v21 row_newbcast:4 row_mask:0xf bank_mask:0xf
    v_fmac_f32_dpp v14, v40, v22 row_newbcast:4 row_mask:0xf bank_mask:0xf
    v_fmac_f32_dpp v15, v40, v23 row_newbcast:4 row_mask:0xf bank_mask:0xf
    v_fmac_f32_dpp v16, v40, v24 row_newbcast:4 row_mask:0xf bank_mask:0xf
    v_fmac_f32_dpp v17, v40, v25 row_newbcast:4 row_mask:0xf bank_mask:0xf
    v_fmac_f32_dpp v18, v40, v26 row_newbcast:4 row_mask:0xf bank_mask:0xf
    v_fmac_f32_dpp v19, v40, v27 row_newbcast:4 row_mask:0xf bank_mask:0xf
    s_waitcnt vmcnt(4)
    v_lshlrev_b32 v20, 16, v56
    v_and_b32 v21, 0xffff0000, v56
    v_lshlrev_b32 v22, 16, v57
    v_and_b32 v23, 0xffff0000, v57
    v_lshlrev_b32 v24, 16, v58
    v_and_b32 v25, 0xffff0000, v58
    v_lshlrev_b32 v26, 16, v59
    v_and_b32 v27, 0xffff0000, v59
    v_fmac_f32_dpp v12, v40, v20 row_newbcast:12 row_mask:0xf bank_mask:0xf
    v_fmac_f32_dpp v13, v40, v21 row_newbcast:12 row_mask:0xf bank_mask:0xf
    v_fmac_f32_dpp v14, v40, v22 row_newbcast:12 row_mask:0xf bank_mask:0xf
    v_fmac_f32_dpp v15, v40, v23 row_newbcast:12 row_mask:0xf bank_mask:0xf
    v_fmac_f32_dpp v16, v40, v24 row_newbcast:12 row_mask:0xf bank_mask:0xf
    v_fmac_f32_dpp v17, v40, v25 row_newbcast:12 row_mask:0xf bank_mask:0xf
    v_fmac_f32_dpp v18, v40, v26 row_newbcast:12 row_mask:0xf bank_mask:0xf
    v_fmac_f32_dpp v19, v40, v27 row_newbcast:12 row_mask:0xf bank_mask:0xf
    s_waitcnt vmcnt(3)
    v_lshlrev_b32 v20, 16, v60
    v_and_b32 v21, 0xffff0000, v60
    v_lshlrev_b32 v22, 16, v61
    v_and_b32 v23, 0xffff0000, v61
    v_lshlrev_b32 v24, 16, v62
    v_and_b32 v25, 0xffff0000, v62
    v_lshlrev_b32 v26, 16, v63
    v_and_b32 v27, 0xffff0000, v63
    v_fmac_f32_dpp v12, v41, v20 row_newbcast:0 row_mask:0xf bank_mask:0xf
    v_fmac_f32_dpp v13, v41, v21 row_newbcast:0 row_mask:0xf bank_mask:0xf
    v_fmac_f32_dpp v14, v41, v22 row_newbcast:0 row_mask:0xf bank_mask:0xf
    v_fmac_f32_dpp v15, v41, v23 row_newbcast:0 row_mask:0xf bank_mask:0xf
    v_fmac_f32_dpp v16, v41, v24 row_newbcast:0 row_mask:0xf bank_mask:0xf
    v_fmac_f32_dpp v17, v41, v25 row_newbcast:0 row_mask:0xf bank_mask:0xf
    v_fmac_f32_dpp v18, v41, v26 row_newbcast:0 row_mask:0xf bank_mask:0xf
    v_fmac_f32_dpp v19, v41, v27 row_newbcast:0 row_mask:0xf bank_mask:0xf
    s_waitcnt vmcnt(2)
    v_lshlrev_b32 v20, 16, v64
    v_and_b32 v21, 0xffff0000, v64
    v_lshlrev_b32 v22, 16, v65
    v_and_b32 v23, 0xffff0000, v65
    v_lshlrev_b32 v24, 16, v66
    v_and_b32 v25, 0xffff0000, v66
    v_lshlrev_b32 v26, 16, v67
    v_and_b32 v27, 0xffff0000, v67
    v_fmac_f32_dpp v12, v41, v20 row_newbcast:8 row_mask:0xf bank_mask:0xf
    v_fmac_f32_dpp v13, v41, v21 row_newbcast:8 row_mask:0xf bank_mask:0xf
    v_fmac_f32_dpp v14, v41, v22 row_newbcast:8 row_mask:0xf bank_mask:0xf
    v_fmac_f32_dpp v15, v41, v23 row_newbcast:8 row_mask:0xf bank_mask:0xf
    v_fmac_f32_dpp v16, v41, v24 row_newbcast:8 row_mask:0xf bank_mask:0xf
    v_fmac_f32_dpp v17, v41, v25 row_newbcast:8 row_mask:0xf bank_mask:0xf
    v_fmac_f32_dpp v18, v41, v26 row_newbcast:8 row_mask:0xf bank_mask:0xf
    v_fmac_f32_dpp v19, v41, v27 row_newbcast:8 row_mask:0xf bank_mask:0xf
    s_waitcnt vmcnt(1)
    v_lshlrev_b32 v20, 16, v68
    v_and_b32 v21, 0xffff0000, v68
    v_lshlrev_b32 v22, 16, v69
    v_and_b32 v23, 0xffff0000, v69
    v_lshlrev_b32 v24, 16, v70
    v_and_b32 v25, 0xffff0000, v70
    v_lshlrev_b32 v26, 16, v71
    v_and_b32 v27, 0xffff0000, v71
    v_fmac_f32_dpp v12, v41, v20 row_newbcast:4 row_mask:0xf bank_mask:0xf
    v_fmac_f32_dpp v13, v41, v21 row_newbcast:4 row_mask:0xf bank_mask:0xf
    v_fmac_f32_dpp v14, v41, v22 row_newbcast:4 row_mask:0xf bank_mask:0xf
    v_fmac_f32_dpp v15, v41, v23 row_newbcast:4 row_mask:0xf bank_mask:0xf
    v_fmac_f32_dpp v16, v41, v24 row_newbcast:4 row_mask:0xf bank_mask:0xf
    v_fmac_f32_dpp v17, v41, v25 row_newbcast:4 row_mask:0xf bank_mask:0xf
    v_fmac_f32_dpp v18, v41, v26 row_newbcast:4 row_mask:0xf bank_mask:0xf
    v_fmac_f32_dpp v19, v41, v27 row_newbcast:4 row_mask:0xf bank_mask:0xf
    s_waitcnt vmcnt(0)
    v_lshlrev_b32 v20, 16, v72
    v_and_b32 v21, 0xffff0000, v72
    v_lshlrev_b32 v22, 16, v73
    v_and_b32 v23, 0xffff0000, v73
    v_lshlrev_b32 v24, 16, v74
    v_and_b32 v25, 0xffff0000, v74
    v_lshlrev_b32 v26, 16, v75
    v_and_b32 v27, 0xffff0000, v75
    v_fmac_f32_dpp v12, v41, v20 row_newbcast:12 row_mask:0xf bank_mask:0xf
    v_fmac_f32_dpp v13, v41, v21 row_newbcast:12 row_mask:0xf bank_mask:0xf
    v_fmac_f32_dpp v14, v41, v22 row_newbcast:12 row_mask:0xf bank_mask:0xf
    v_fmac_f32_dpp v15, v41, v23 row_newbcast:12 row_mask:0xf bank_mask:0xf
    v_fmac_f32_dpp v16, v41, v24 row_newbcast:12 row_mask:0xf bank_mask:0xf
    v_fmac_f32_dpp v17, v41, v25 row_newbcast:12 row_mask:0xf bank_mask:0xf
    v_fmac_f32_dpp v18, v41, v26 row_newbcast:12 row_mask:0xf bank_mask:0xf
    v_fmac_f32_dpp v19, v41, v27 row_newbcast:12 row_mask:0xf bank_mask:0xf
    s_branch L_fin
L_drain:
    buffer_load_dwordx4 v[68:71], v1, s[28:31], s63 offen offset:2048 nt
    v_dot2_f32_bf16 v8, v44, v4, 0
    v_dot2_f32_bf16 v8, v45, v5, v8
    v_dot2_f32_bf16 v8, v46, v6, v8
    v_dot2_f32_bf16 v8, v47, v7, v8
    s_waitcnt vmcnt(5)
    buffer_load_dwordx4 v[72:75], v1, s[28:31], s63 offen offset:3072 nt
    v_dot2_f32_bf16 v9, v48, v4, 0
    v_dot2_f32_bf16 v9, v49, v5, v9
    v_dot2_f32_bf16 v9, v50, v6, v9
    v_dot2_f32_bf16 v9, v51, v7, v9
    s_waitcnt vmcnt(5)
    v_dot2_f32_bf16 v10, v52, v4, 0
    v_dot2_f32_bf16 v10, v53, v5, v10
    v_dot2_f32_bf16 v10, v54, v6, v10
    v_dot2_f32_bf16 v10, v55, v7, v10
    s_waitcnt vmcnt(4)
    v_dot2_f32_bf16 v11, v56, v4, 0
    v_dot2_f32_bf16 v11, v57, v5, v11
    v_dot2_f32_bf16 v11, v58, v6, v11
    v_dot2_f32_bf16 v11, v59, v7, v11
    v_add_f32_dpp v8, v8, v8 row_ror:8 row_mask:0xf bank_mask:0x3
    v_add_f32_dpp v10, v10, v10 row_ror:8 row_mask:0xf bank_mask:0x3
    s_nop 0
    v_add_f32_dpp v8, v9, v9 row_ror:8 row_mask:0xf bank_mask:0xc
    v_add_f32_dpp v10, v11, v11 row_ror:8 row_mask:0xf bank_mask:0xc
    s_nop 0
    v_add_f32_dpp v8, v8, v8 row_half_mirror row_mask:0xf bank_mask:0x5
    s_nop 1
    v_add_f32_dpp v8, v10, v10 row_half_mirror row_mask:0xf bank_mask:0xa
    s_nop 1
    v_add_f32_dpp v8, v8, v8 quad_perm:[1,0,3,2] row_mask:0xf bank_mask:0xf
    s_nop 1
    v_add_f32_dpp v8, v8, v8 quad_perm:[2,3,0,1] row_mask:0xf bank_mask:0xf
    v_mul_f32 v8, 0x3e0293ee, v8
    s_nop 1
    v_max_f32_dpp v28, v8, v8 row_ror:4 row_mask:0xf bank_mask:0xf
    s_nop 1
    v_max_f32_dpp v28, v28, v28 row_ror:8 row_mask:0xf bank_mask:0xf
    v_max_f32 v28, v2, v28
    v_sub_f32 v29, v2, v28
    v_sub_f32 v30, v8, v28
    v_exp_f32 v29, v29
    v_exp_f32 v30, v30
    v_mov_b32 v2, v28
    v_mul_f32 v12, v29, v12
    v_mul_f32 v13, v29, v13
    v_mul_f32 v14, v29, v14
    v_mul_f32 v15, v29, v15
    v_mul_f32 v16, v29, v16
    v_mul_f32 v17, v29, v17
    v_mul_f32 v18, v29, v18
    v_mul_f32 v19, v29, v19
    v_fma_f32 v3, v3, v29, v30
    s_waitcnt vmcnt(3)
    v_lshlrev_b32 v20, 16, v60
    v_and_b32 v21, 0xffff0000, v60
    v_lshlrev_b32 v22, 16, v61
    v_and_b32 v23, 0xffff0000, v61
    v_lshlrev_b32 v24, 16, v62
    v_and_b32 v25, 0xffff0000, v62
    v_lshlrev_b32 v26, 16, v63
    v_and_b32 v27, 0xffff0000, v63
    v_fmac_f32_dpp v12, v30, v20 row_newbcast:0 row_mask:0xf bank_mask:0xf
    v_fmac_f32_dpp v13, v30, v21 row_newbcast:0 row_mask:0xf bank_mask:0xf
    v_fmac_f32_dpp v14, v30, v22 row_newbcast:0 row_mask:0xf bank_mask:0xf
    v_fmac_f32_dpp v15, v30, v23 row_newbcast:0 row_mask:0xf bank_mask:0xf
    v_fmac_f32_dpp v16, v30, v24 row_newbcast:0 row_mask:0xf bank_mask:0xf
    v_fmac_f32_dpp v17, v30, v25 row_newbcast:0 row_mask:0xf bank_mask:0xf
    v_fmac_f32_dpp v18, v30, v26 row_newbcast:0 row_mask:0xf bank_mask:0xf
    v_fmac_f32_dpp v19, v30, v27 row_newbcast:0 row_mask:0xf bank_mask:0xf
    s_waitcnt vmcnt(2)
    v_lshlrev_b32 v20, 16, v64
    v_and_b32 v21, 0xffff0000, v64
    v_lshlrev_b32 v22, 16, v65
    v_and_b32 v23, 0xffff0000, v65
    v_lshlrev_b32 v24, 16, v66
    v_and_b32 v25, 0xffff0000, v66
    v_lshlrev_b32 v26, 16, v67
    v_and_b32 v27, 0xffff0000, v67
    v_fmac_f32_dpp v12, v30, v20 row_newbcast:8 row_mask:0xf bank_mask:0xf
    v_fmac_f32_dpp v13, v30, v21 row_newbcast:8 row_mask:0xf bank_mask:0xf
    v_fmac_f32_dpp v14, v30, v22 row_newbcast:8 row_mask:0xf bank_mask:0xf
    v_fmac_f32_dpp v15, v30, v23 row_newbcast:8 row_mask:0xf bank_mask:0xf
    v_fmac_f32_dpp v16, v30, v24 row_newbcast:8 row_mask:0xf bank_mask:0xf
    v_fmac_f32_dpp v17, v30, v25 row_newbcast:8 row_mask:0xf bank_mask:0xf
    v_fmac_f32_dpp v18, v30, v26 row_newbcast:8 row_mask:0xf bank_mask:0xf
    v_fmac_f32_dpp v19, v30, v27 row_newbcast:8 row_mask:0xf bank_mask:0xf
    s_waitcnt vmcnt(1)
    v_lshlrev_b32 v20, 16, v68
    v_and_b32 v21, 0xffff0000, v68
    v_lshlrev_b32 v22, 16, v69
    v_and_b32 v23, 0xffff0000, v69
    v_lshlrev_b32 v24, 16, v70
    v_and_b32 v25, 0xffff0000, v70
    v_lshlrev_b32 v26, 16, v71
    v_and_b32 v27, 0xffff0000, v71
    v_fmac_f32_dpp v12, v30, v20 row_newbcast:4 row_mask:0xf bank_mask:0xf
    v_fmac_f32_dpp v13, v30, v21 row_newbcast:4 row_mask:0xf bank_mask:0xf
    v_fmac_f32_dpp v14, v30, v22 row_newbcast:4 row_mask:0xf bank_mask:0xf
    v_fmac_f32_dpp v15, v30, v23 row_newbcast:4 row_mask:0xf bank_mask:0xf
    v_fmac_f32_dpp v16, v30, v24 row_newbcast:4 row_mask:0xf bank_mask:0xf
    v_fmac_f32_dpp v17, v30, v25 row_newbcast:4 row_mask:0xf bank_mask:0xf
    v_fmac_f32_dpp v18, v30, v26 row_newbcast:4 row_mask:0xf bank_mask:0xf
    v_fmac_f32_dpp v19, v30, v27 row_newbcast:4 row_mask:0xf bank_mask:0xf
    s_waitcnt vmcnt(0)
    v_lshlrev_b32 v20, 16, v72
    v_and_b32 v21, 0xffff0000, v72
    v_lshlrev_b32 v22, 16, v73
    v_and_b32 v23, 0xffff0000, v73
    v_lshlrev_b32 v24, 16, v74
    v_and_b32 v25, 0xffff0000, v74
    v_lshlrev_b32 v26, 16, v75
    v_and_b32 v27, 0xffff0000, v75
    v_fmac_f32_dpp v12, v30, v20 row_newbcast:12 row_mask:0xf bank_mask:0xf
    v_fmac_f32_dpp v13, v30, v21 row_newbcast:12 row_mask:0xf bank_mask:0xf
    v_fmac_f32_dpp v14, v30, v22 row_newbcast:12 row_mask:0xf bank_mask:0xf
    v_fmac_f32_dpp v15, v30, v23 row_newbcast:12 row_mask:0xf bank_mask:0xf
    v_fmac_f32_dpp v16, v30, v24 row_newbcast:12 row_mask:0xf bank_mask:0xf
    v_fmac_f32_dpp v17, v30, v25 row_newbcast:12 row_mask:0xf bank_mask:0xf
    v_fmac_f32_dpp v18, v30, v26 row_newbcast:12 row_mask:0xf bank_mask:0xf
    v_fmac_f32_dpp v19, v30, v27 row_newbcast:12 row_mask:0xf bank_mask:0xf
L_fin:
    v_add_f32_dpp v3, v3, v3 row_ror:4 row_mask:0xf bank_mask:0xf
    v_mov_b32 v20, v2
    v_mov_b32 v21, v2
    v_add_f32_dpp v3, v3, v3 row_ror:8 row_mask:0xf bank_mask:0xf
    s_nop 0
    v_permlane32_swap_b32 v20, v21
    v_max_f32 v20, v20, v21
    v_mov_b32 v21, v20
    s_nop 1
    v_permlane16_swap_b32 v20, v21
    v_max_f32 v28, v20, v21
    v_sub_f32 v29, v2, v28
    v_exp_f32 v29, v29
    s_lshl_b32 s34, s22, 13
    v_add_u32 v1, s34, v1
    s_lshl_b32 s35, s23, 10
    v_add_u32 v31, s35, v1
    v_mul_f32 v3, v29, v3
    v_mul_f32 v12, v29, v12
    v_mul_f32 v13, v29, v13
    v_mul_f32 v14, v29, v14
    v_mul_f32 v15, v29, v15
    v_mul_f32 v16, v29, v16
    v_mul_f32 v17, v29, v17
    v_mul_f32 v18, v29, v18
    v_mul_f32 v19, v29, v19
    v_mov_b32 v21, v3
    s_nop 1
    v_permlane32_swap_b32 v3, v21
    v_permlane32_swap_b32 v12, v13
    v_permlane32_swap_b32 v14, v15
    v_permlane32_swap_b32 v16, v17
    v_permlane32_swap_b32 v18, v19
    v_add_f32 v3, v3, v21
    v_add_f32 v12, v12, v13
    v_add_f32 v14, v14, v15
    v_add_f32 v16, v16, v17
    v_add_f32 v18, v18, v19
    v_mov_b32 v21, v3
    v_permlane16_swap_b32 v12, v14
    v_permlane16_swap_b32 v16, v18
    v_permlane16_swap_b32 v3, v21
    v_add_f32 v12, v12, v14
    v_add_f32 v13, v16, v18
    v_add_f32 v15, v3, v21
    v_mov_b32 v14, v28
    global_store_dwordx4 v31, v[12:15], s[20:21] sc1
    s_waitcnt vmcnt(0)
    s_mov_b64 exec, 1
    global_atomic_add v29, v34, v33, s[20:21] offset:4 sc0
    s_waitcnt vmcnt(0)
    v_readfirstlane_b32 s36, v29
    s_mov_b64 exec, -1
    s_cmp_eq_u32 s36, 7
    s_cbranch_scc0 L_end2
    global_load_dwordx4 v[44:47], v1, s[20:21] offset:0 sc1
    global_load_dwordx4 v[48:51], v1, s[20:21] offset:1024 sc1
    global_load_dwordx4 v[52:55], v1, s[20:21] offset:2048 sc1
    global_load_dwordx4 v[56:59], v1, s[20:21] offset:3072 sc1
    v_add_u32 v1, 4096, v1
    global_load_dwordx4 v[60:63], v1, s[20:21] offset:0 sc1
    global_load_dwordx4 v[64:67], v1, s[20:21] offset:1024 sc1
    global_load_dwordx4 v[68:71], v1, s[20:21] offset:2048 sc1
    global_load_dwordx4 v[72:75], v1, s[20:21] offset:3072 sc1
    v_and_b32 v31, 15, v0
    v_lshlrev_b32 v31, 4, v31
    v_lshrrev_b32 v30, 4, v0
    v_lshl_add_u32 v31, v30, 2, v31
    s_lshl_b32 s34, s22, 8
    v_add_u32 v31, s34, v31
    s_waitcnt vmcnt(0)
    v_max3_f32 v28, v46, v50, v54
    v_max3_f32 v29, v58, v62, v66
    v_max3_f32 v28, v28, v70, v74
    v_max_f32 v28, v28, v29
    v_sub_f32 v46, v46, v28
    v_sub_f32 v50, v50, v28
    v_sub_f32 v54, v54, v28
    v_sub_f32 v58, v58, v28
    v_sub_f32 v62, v62, v28
    v_sub_f32 v66, v66, v28
    v_sub_f32 v70, v70, v28
    v_sub_f32 v74, v74, v28
    v_exp_f32 v46, v46
    v_exp_f32 v50, v50
    v_exp_f32 v54, v54
    v_exp_f32 v58, v58
    v_exp_f32 v62, v62
    v_exp_f32 v66, v66
    v_exp_f32 v70, v70
    v_exp_f32 v74, v74
    v_mul_f32 v3, v46, v47
    v_mul_f32 v12, v46, v44
    v_mul_f32 v13, v46, v45
    v_fmac_f32 v3, v50, v51
    v_fmac_f32 v12, v50, v48
    v_fmac_f32 v13, v50, v49
    v_fmac_f32 v3, v54, v55
    v_fmac_f32 v12, v54, v52
    v_fmac_f32 v13, v54, v53
    v_fmac_f32 v3, v58, v59
    v_fmac_f32 v12, v58, v56
    v_fmac_f32 v13, v58, v57
    v_fmac_f32 v3, v62, v63
    v_fmac_f32 v12, v62, v60
    v_fmac_f32 v13, v62, v61
    v_fmac_f32 v3, v66, v67
    v_fmac_f32 v12, v66, v64
    v_fmac_f32 v13, v66, v65
    v_fmac_f32 v3, v70, v71
    v_fmac_f32 v12, v70, v68
    v_fmac_f32 v13, v70, v69
    v_fmac_f32 v3, v74, v75
    v_fmac_f32 v12, v74, v72
    v_fmac_f32 v13, v74, v73
    v_rcp_f32 v3, v3
    s_nop 0
    v_mul_f32 v12, v12, v3
    v_mul_f32 v13, v13, v3
    s_nop 1
    v_permlane32_swap_b32 v12, v13
    v_cvt_pk_bf16_f32 v20, v12, v13
    global_store_dword v31, v20, s[16:17]
L_end2:
L_end:
    s_endpgm
.section .rodata,"a"
.p2align 6
.amdhsa_kernel standalone__tree_speculative_verify_tree_attention_over_candidate_token_tree__decode_kernel
  .amdhsa_next_free_vgpr 76
  .amdhsa_next_free_sgpr 72
  .amdhsa_accum_offset 76
  .amdhsa_group_segment_fixed_size 0
  .amdhsa_kernarg_size 72
  .amdhsa_user_sgpr_count 2
  .amdhsa_user_sgpr_kernarg_segment_ptr 1
  .amdhsa_system_sgpr_workgroup_id_x 1
  .amdhsa_float_denorm_mode_32 3
.end_amdhsa_kernel
```
